```python
import torch

def _softmax(x, axis=-1):
    return torch.softmax(x, dim=axis)
def _gelu(x):
    return torch.nn.functional.gelu(x, approximate="tanh")
def _silu(x):
    return torch.nn.functional.silu(x)
def _sigmoid(x):
    return torch.sigmoid(x)
def _layernorm(x, axis=-1, eps=1e-5):
    m = x.mean(dim=axis, keepdim=True)
    v = x.var(dim=axis, keepdim=True, unbiased=False)
    return (x - m) / torch.sqrt(v + eps)
def _scatter_add(tgt, idx, src, axis=0):
    return tgt.clone().index_add_(axis, idx, src)
def _segment_sum(src, seg, n):
    out = torch.zeros((n,) + src.shape[1:], dtype=src.dtype)
    return out.index_add_(0, seg, src)
def _pad(x, pw):
    flat = tuple(v for pair in reversed(pw) for v in pair)
    return torch.nn.functional.pad(x, flat)

kernel_name = 'recurrent_scan__sliding_block_cached__dense_activation_squared_relu__decode'

def setup_inputs():

    _w = (lambda a: (lambda t: t.to(torch.bfloat16) if t.is_floating_point() else t)(torch.as_tensor(a)))
    def _A_setup():
        B, Sq, D = 1, 1, 640
        Hq, Hkv, Sk, Dh = 32, 32, 32768, 192
        assert Hq % Hkv == 0, (Hq, Hkv)
        return {
            "x": _w((lambda *s: torch.randn(*s, dtype=torch.bfloat16) * 0.05)(B, Sq, D)),
            "k_cache": _w((lambda *s: torch.randn(*s, dtype=torch.bfloat16) * 0.8)(B, Hkv, Sk, Dh)),
            "v_cache": _w((lambda *s: torch.randn(*s, dtype=torch.bfloat16) * 0.2)(B, Hkv, Sk, Dh)),
            "wq": _w((lambda *s: torch.randn(*s, dtype=torch.bfloat16) * 0.8)(D, Hq * Dh) * (D ** -0.5)),
            "wo": _w((lambda *s: torch.randn(*s, dtype=torch.bfloat16) * 0.2)(Hq * Dh, D) * ((Hq * Dh) ** -0.5)),
        }
    _A_in = _A_setup()

    def _B_setup():
        B, S, D, F = 1, 1, 640, 1536
        return {
            "x": _w((lambda *s: torch.randn(*s, dtype=torch.bfloat16) * 0.05)(B, S, D)),
            "w1": _w((lambda *s: torch.randn(*s, dtype=torch.bfloat16) * 0.1)(D, F)),
            "b1": _w((lambda *s: torch.randn(*s, dtype=torch.bfloat16) * 0.1)(F)),
            "w2": _w((lambda *s: torch.randn(*s, dtype=torch.bfloat16) * 0.1)(F, D)),
            "b2": _w((lambda *s: torch.randn(*s, dtype=torch.bfloat16) * 0.1)(D)),
        }
    _B_in = _B_setup()

    return {
        "A_x": _A_in["x"],
        "A_k_cache": _A_in["k_cache"],
        "A_v_cache": _A_in["v_cache"],
        "A_wq": _A_in["wq"],
        "A_wo": _A_in["wo"],
        "B_x": _B_in["x"],
        "B_w1": _B_in["w1"],
        "B_b1": _B_in["b1"],
        "B_w2": _B_in["w2"],
        "B_b2": _B_in["b2"],
    }

def reference(A_x, A_k_cache, A_v_cache, A_wq, A_wo, B_x, B_w1, B_b1, B_w2, B_b2):
    def _A_ref(x, k_cache, v_cache, wq, wo):
        B, Sq, D = x.shape
        Hq, Dh = 32, 192
        Hkv, Sk = k_cache.shape[1], k_cache.shape[2]
        W = min(4096, max(256, Sk // 4))
        rep = Hq // Hkv
        q = (lambda x, *d: x.permute(*d))((x @ wq).reshape(B, Sq, Hq, Dh), 0, 2, 1, 3)
        k = (lambda x, n, axis: torch.repeat_interleave(x, n, dim=axis))(k_cache[:, :, Sk - W:, :], rep, axis=1)
        v = (lambda x, n, axis: torch.repeat_interleave(x, n, dim=axis))(v_cache[:, :, Sk - W:, :], rep, axis=1)
        scores = torch.einsum("bhqd,bhkd->bhqk", q, k) * (Dh ** -0.5)
        p = _softmax(scores, axis=-1)
        o = torch.einsum("bhqk,bhkd->bhqd", p, v)
        return (lambda x, *d: x.permute(*d))(o, 0, 2, 1, 3).reshape(B, Sq, Hq * Dh) @ wo

    def _B_ref(x, w1, b1, w2, b2):
        h = torch.einsum("bsd,df->bsf", x, w1) + b1
        zero = torch.zeros_like(h)
        r = torch.where(h > zero, h, zero)
        h = r * r
        out = torch.einsum("bsf,fd->bsd", h, w2) + b2
        return out

    x = A_x
    xn = _layernorm(x, axis=-1)
    s = _A_ref(xn, A_k_cache, A_v_cache, A_wq, A_wo)
    g = _silu(_B_ref(xn, B_w1, B_b1, B_w2, B_b2))
    return x + s * g
```

```asm
; @launch grid=(256,1,1) block=(512,1,1) lds=28800
.amdgcn_target "amdgcn-amd-amdhsa--gfx950"
.text
.globl recurrent_scan__sliding_block_cached__dense_activation_squared_relu__decode_kernel
.p2align 8
.type recurrent_scan__sliding_block_cached__dense_activation_squared_relu__decode_kernel,@function
recurrent_scan__sliding_block_cached__dense_activation_squared_relu__decode_kernel:
L_start:
    s_load_dwordx16 s[4:19], s[0:1], 0
    s_load_dwordx8 s[20:27], s[0:1], 64
    s_load_dwordx2 s[28:29], s[0:1], 96
    s_cmp_ge_u32 s2, 32
    s_cbranch_scc1 L_nocpf
    s_getpc_b64 s[36:37]
L_pc:
    v_lshlrev_b32 v8, 4, v0
    v_min_u32 v8, L_last-L_pc, v8
    global_load_dword v59, v8, s[36:37]
L_nocpf:
    s_cmp_ge_u32 s2, 256
    s_cbranch_scc1 L_end
    v_lshrrev_b32 v7, 6, v0
    v_and_b32 v1, 63, v0
    v_and_b32 v2, 7, v0
    v_readfirstlane_b32 s32, v7
    v_bfe_u32 v3, v0, 3, 3
    s_and_b32 s30, s2, 7
    s_lshl_b32 s30, s30, 2
    s_bfe_u32 s33, s2, 0x20003
    s_add_u32 s30, s30, s33
    s_lshr_b32 s31, s2, 5
    s_lshl_b32 s34, s30, 3
    s_add_u32 s34, s34, s31
    v_mul_u32_u24 v4, 384, v3
    v_lshl_add_u32 v4, v2, 4, v4
    s_lshl_b32 s35, s30, 12
    s_lshl_b32 s36, s32, 3
    s_add_u32 s35, s35, s36
    s_add_u32 s35, s35, s31
    s_addk_i32 s35, 3584
    s_mul_i32 s35, s35, 3072
    s_mov_b32 s33, 196608
    v_mov_b32 v5, v4
    s_cmp_ge_u32 s32, 4
    s_cbranch_scc1 L_notctl
    s_cmp_eq_u32 s32, 3
    s_cselect_b32 s44, 0, 2
    s_cselect_b32 s41, 5, 7
    s_cselect_b32 s43, 0, s32
    s_lshl_b32 s40, 3072, s44
    s_lshl_b32 s42, 96, s44
    s_mul_i32 s37, s31, 160
    s_mul_i32 s36, s40, s31
    s_mul_i32 s36, s36, 80
    s_mul_i32 s38, s30, s42
    s_add_u32 s36, s36, s38
    s_lshl_b32 s43, s43, 7
    s_add_u32 s36, s36, s43
    s_mul_i32 s38, s40, 10
    v_min_u32 v25, s41, v2
    v_lshlrev_b32 v25, 4, v25
    v_mad_u32_u24 v25, v3, s38, v25
    v_add_u32 v25, s36, v25
    v_lshlrev_b32 v13, 4, v1
    v_lshlrev_b32 v12, 2, v1
    v_mul_u32_u24 v11, 20, v3
    v_add_u32 v11, s37, v11
    s_waitcnt lgkmcnt(0)
    s_load_dword s49, s[28:29], 0
    s_cmp_eq_u32 s32, 3
    s_cselect_b64 s[10:11], s[16:17], s[10:11]
    global_load_dwordx4 v[14:17], v13, s[4:5]
    global_load_dword v18, v12, s[4:5] offset:1024
    global_load_dwordx4 v[20:23], v11, s[4:5]
    global_load_dword v24, v11, s[4:5] offset:16
    global_load_dwordx4 v[160:163], v25, s[10:11] nt
    v_add_u32 v25, s40, v25
    global_load_dwordx4 v[164:167], v25, s[10:11] nt
    v_add_u32 v25, s40, v25
    global_load_dwordx4 v[168:171], v25, s[10:11] nt
    v_add_u32 v25, s40, v25
    global_load_dwordx4 v[172:175], v25, s[10:11] nt
    v_add_u32 v25, s40, v25
    global_load_dwordx4 v[176:179], v25, s[10:11] nt
    v_add_u32 v25, s40, v25
    global_load_dwordx4 v[180:183], v25, s[10:11] nt
    v_add_u32 v25, s40, v25
    global_load_dwordx4 v[184:187], v25, s[10:11] nt
    v_add_u32 v25, s40, v25
    global_load_dwordx4 v[188:191], v25, s[10:11] nt
    v_add_u32 v25, s40, v25
    global_load_dwordx4 v[192:195], v25, s[10:11] nt
    v_add_u32 v25, s40, v25
    global_load_dwordx4 v[196:199], v25, s[10:11] nt
    s_add_u32 s6, s6, s35
    s_addc_u32 s7, s7, 0
    s_add_u32 s8, s8, s35
    s_addc_u32 s9, s9, 0
    s_getreg_b32 s53, hwreg(HW_REG_XCC_ID)
    s_and_b32 s53, s53, 7
    s_lshl_b32 s53, s53, 25
    s_add_u32 s53, s53, 0x3f800000
    v_mov_b32 v10, 0x3acccccd
    v_lshlrev_b32 v8, 4, v2
    v_mov_b32 v9, 0xffff
    v_lshlrev_b32 v8, v8, v9
    v_lshrrev_b32 v9, 1, v2
    v_cmp_eq_u32 s[40:41], 0, v9
    v_cmp_eq_u32 s[42:43], 1, v9
    v_cmp_eq_u32 s[44:45], 2, v9
    v_cmp_eq_u32 s[46:47], 3, v9
    v_cndmask_b32 v60, 0, v8, s[40:41]
    v_cndmask_b32 v61, 0, v8, s[42:43]
    v_cndmask_b32 v62, 0, v8, s[44:45]
    v_cndmask_b32 v63, 0, v8, s[46:47]
    v_mov_b32 v27, s53
    s_cmp_eq_u32 s32, 3
    s_cselect_b32 s36, 7, 8
    v_cmp_eq_u32 vcc, s36, v2
    v_lshrrev_b32 v26, 4, v1
    v_lshl_add_u32 v26, v26, 3, v2
    s_lshl_b32 s36, s34, 11
    s_lshl_b32 s38, s32, 9
    s_add_u32 s36, s36, s38
    s_add_u32 s36, s36, 524288
    v_lshl_add_u32 v26, v26, 4, s36
    s_waitcnt lgkmcnt(0)
    s_mul_i32 s49, s49, 0x9E3779B1
    s_add_u32 s49, s49, 0x7F4A7C15
    s_waitcnt vmcnt(12)
    global_load_dwordx4 v[64:67], v4, s[6:7] offset:0 nt
    global_load_dwordx4 v[68:71], v4, s[6:7] offset:128 nt
    global_load_dwordx4 v[72:75], v4, s[6:7] offset:256 nt
    v_add_u32 v4, s33, v4
    v_lshlrev_b32 v44, 16, v14
    v_and_b32 v45, 0xffff0000, v14
    v_lshlrev_b32 v46, 16, v15
    v_and_b32 v47, 0xffff0000, v15
    v_lshlrev_b32 v48, 16, v16
    v_and_b32 v49, 0xffff0000, v16
    v_lshlrev_b32 v50, 16, v17
    v_and_b32 v51, 0xffff0000, v17
    v_lshlrev_b32 v52, 16, v18
    v_and_b32 v53, 0xffff0000, v18
    v_add_f32 v8, v44, v45
    v_add_f32 v9, v46, v47
    v_add_f32 v8, v8, v48
    v_add_f32 v9, v9, v49
    v_add_f32 v8, v8, v50
    v_add_f32 v9, v9, v51
    v_add_f32 v8, v8, v52
    v_add_f32 v9, v9, v53
    v_add_f32 v8, v8, v9
    s_nop 1
    v_add_f32_dpp v8, v8, v8 row_shr:1 row_mask:0xf bank_mask:0xf
    s_nop 1
    v_add_f32_dpp v8, v8, v8 row_shr:2 row_mask:0xf bank_mask:0xf
    s_nop 1
    v_add_f32_dpp v8, v8, v8 row_shr:4 row_mask:0xf bank_mask:0xf
    s_nop 1
    v_add_f32_dpp v8, v8, v8 row_shr:8 row_mask:0xf bank_mask:0xf
    s_nop 1
    v_add_f32_dpp v8, v8, v8 row_bcast:15 row_mask:0xa bank_mask:0xf
    s_nop 1
    v_add_f32_dpp v8, v8, v8 row_bcast:31 row_mask:0xc bank_mask:0xf
    s_nop 0
    v_readlane_b32 s36, v8, 63
    s_nop 1
    v_mul_f32 v11, s36, v10
    v_sub_f32 v44, v44, v11
    v_sub_f32 v45, v45, v11
    v_sub_f32 v46, v46, v11
    v_sub_f32 v47, v47, v11
    v_sub_f32 v48, v48, v11
    v_sub_f32 v49, v49, v11
    v_sub_f32 v50, v50, v11
    v_sub_f32 v51, v51, v11
    v_sub_f32 v52, v52, v11
    v_sub_f32 v53, v53, v11
    v_mul_f32 v8, v44, v44
    v_mul_f32 v9, v45, v45
    v_fmac_f32 v8, v46, v46
    v_fmac_f32 v9, v47, v47
    v_fmac_f32 v8, v48, v48
    v_fmac_f32 v9, v49, v49
    v_fmac_f32 v8, v50, v50
    v_fmac_f32 v9, v51, v51
    v_fmac_f32 v8, v52, v52
    v_fmac_f32 v9, v53, v53
    v_add_f32 v8, v8, v9
    v_cvt_pk_bf16_f32 v11, 0, v11
    s_waitcnt vmcnt(13)
    v_add_f32_dpp v8, v8, v8 row_shr:1 row_mask:0xf bank_mask:0xf
    v_lshlrev_b32 v44, 16, v20
    v_and_b32 v45, 0xffff0000, v20
    v_lshlrev_b32 v46, 16, v21
    v_add_f32_dpp v8, v8, v8 row_shr:2 row_mask:0xf bank_mask:0xf
    v_and_b32 v47, 0xffff0000, v21
    v_lshlrev_b32 v48, 16, v22
    v_and_b32 v49, 0xffff0000, v22
    v_add_f32_dpp v8, v8, v8 row_shr:4 row_mask:0xf bank_mask:0xf
    v_lshlrev_b32 v50, 16, v23
    v_and_b32 v51, 0xffff0000, v23
    v_lshlrev_b32 v52, 16, v24
    v_add_f32_dpp v8, v8, v8 row_shr:8 row_mask:0xf bank_mask:0xf
    v_and_b32 v53, 0xffff0000, v24
    v_sub_f32 v44, v44, v11
    v_sub_f32 v45, v45, v11
    v_add_f32_dpp v8, v8, v8 row_bcast:15 row_mask:0xa bank_mask:0xf
    v_sub_f32 v46, v46, v11
    v_sub_f32 v47, v47, v11
    v_sub_f32 v48, v48, v11
    v_add_f32_dpp v8, v8, v8 row_bcast:31 row_mask:0xc bank_mask:0xf
    v_sub_f32 v49, v49, v11
    v_sub_f32 v50, v50, v11
    v_sub_f32 v51, v51, v11
    v_readlane_b32 s36, v8, 63
    v_sub_f32 v52, v52, v11
    v_sub_f32 v53, v53, v11
    v_mul_f32 v12, s36, v10
    v_cvt_pk_bf16_f32 v12, 0, v12
    v_add_f32 v12, 0x3727c5ac, v12
    v_cvt_pk_bf16_f32 v12, 0, v12
    v_sqrt_f32 v12, v12
    v_cvt_pk_bf16_f32 v44, 0, v44
    v_cvt_pk_bf16_f32 v45, 0, v45
    v_cvt_pk_bf16_f32 v12, 0, v12
    v_cvt_pk_bf16_f32 v46, 0, v46
    v_cvt_pk_bf16_f32 v47, 0, v47
    v_rcp_f32 v13, v12
    v_cvt_pk_bf16_f32 v48, 0, v48
    v_cvt_pk_bf16_f32 v49, 0, v49
    v_cvt_pk_bf16_f32 v50, 0, v50
    v_cvt_pk_bf16_f32 v51, 0, v51
    v_cvt_pk_bf16_f32 v52, 0, v52
    v_cvt_pk_bf16_f32 v53, 0, v53
    v_mul_f32 v200, v44, v13
    v_mul_f32 v201, v45, v13
    v_mul_f32 v202, v46, v13
    v_mul_f32 v203, v47, v13
    v_mul_f32 v204, v48, v13
    v_mul_f32 v205, v49, v13
    v_mul_f32 v206, v50, v13
    v_mul_f32 v207, v51, v13
    v_mul_f32 v208, v52, v13
    v_mul_f32 v209, v53, v13
    v_fma_f32 v44, -v200, v12, v44
    v_fma_f32 v45, -v201, v12, v45
    v_fma_f32 v46, -v202, v12, v46
    v_fma_f32 v47, -v203, v12, v47
    v_fma_f32 v48, -v204, v12, v48
    v_fma_f32 v49, -v205, v12, v49
    v_fma_f32 v50, -v206, v12, v50
    v_fma_f32 v51, -v207, v12, v51
    v_fma_f32 v52, -v208, v12, v52
    v_fma_f32 v53, -v209, v12, v53
    v_fmac_f32 v200, v44, v13
    v_fmac_f32 v201, v45, v13
    v_fmac_f32 v202, v46, v13
    v_fmac_f32 v203, v47, v13
    v_fmac_f32 v204, v48, v13
    v_fmac_f32 v205, v49, v13
    v_fmac_f32 v206, v50, v13
    v_fmac_f32 v207, v51, v13
    v_fmac_f32 v208, v52, v13
    v_fmac_f32 v209, v53, v13
    v_mov_b32 v9, s49
    v_cvt_pk_bf16_f32 v200, v200, v200
    v_cvt_pk_bf16_f32 v201, v201, v201
    v_cvt_pk_bf16_f32 v202, v202, v202
    v_cvt_pk_bf16_f32 v203, v203, v203
    v_cvt_pk_bf16_f32 v204, v204, v204
    v_cvt_pk_bf16_f32 v205, v205, v205
    v_cvt_pk_bf16_f32 v206, v206, v206
    v_cvt_pk_bf16_f32 v207, v207, v207
    v_cvt_pk_bf16_f32 v208, v208, v208
    v_cvt_pk_bf16_f32 v209, v209, v209
    v_and_b32 v212, v200, v60
    v_and_b32 v213, v200, v61
    v_and_b32 v214, v200, v62
    v_and_b32 v215, v200, v63
    v_and_b32 v216, v201, v60
    v_and_b32 v217, v201, v61
    v_and_b32 v218, v201, v62
    v_and_b32 v219, v201, v63
    s_waitcnt vmcnt(12)
    v_mfma_f32_16x16x32_bf16 v[32:35], v[212:215], v[160:163], 0
    v_and_b32 v220, v202, v60
    v_and_b32 v221, v202, v61
    v_and_b32 v222, v202, v62
    v_and_b32 v223, v202, v63
    s_waitcnt vmcnt(11)
    v_mfma_f32_16x16x32_bf16 v[32:35], v[216:219], v[164:167], v[32:35]
    v_and_b32 v224, v203, v60
    v_and_b32 v225, v203, v61
    v_and_b32 v226, v203, v62
    v_and_b32 v227, v203, v63
    s_waitcnt vmcnt(10)
    v_mfma_f32_16x16x32_bf16 v[32:35], v[220:223], v[168:171], v[32:35]
    v_and_b32 v228, v204, v60
    v_and_b32 v229, v204, v61
    v_and_b32 v230, v204, v62
    v_and_b32 v231, v204, v63
    s_waitcnt vmcnt(9)
    v_mfma_f32_16x16x32_bf16 v[32:35], v[224:227], v[172:175], v[32:35]
    v_and_b32 v232, v205, v60
    v_and_b32 v233, v205, v61
    v_and_b32 v234, v205, v62
    v_and_b32 v235, v205, v63
    s_waitcnt vmcnt(8)
    v_mfma_f32_16x16x32_bf16 v[32:35], v[228:231], v[176:179], v[32:35]
    v_and_b32 v236, v206, v60
    v_and_b32 v237, v206, v61
    v_and_b32 v238, v206, v62
    v_and_b32 v239, v206, v63
    s_waitcnt vmcnt(7)
    v_mfma_f32_16x16x32_bf16 v[32:35], v[232:235], v[180:183], v[32:35]
    v_and_b32 v240, v207, v60
    v_and_b32 v241, v207, v61
    v_and_b32 v242, v207, v62
    v_and_b32 v243, v207, v63
    s_waitcnt vmcnt(6)
    v_mfma_f32_16x16x32_bf16 v[32:35], v[236:239], v[184:187], v[32:35]
    v_and_b32 v244, v208, v60
    v_and_b32 v245, v208, v61
    v_and_b32 v246, v208, v62
    v_and_b32 v247, v208, v63
    s_waitcnt vmcnt(5)
    v_mfma_f32_16x16x32_bf16 v[32:35], v[240:243], v[188:191], v[32:35]
    v_and_b32 v248, v209, v60
    v_and_b32 v249, v209, v61
    v_and_b32 v250, v209, v62
    v_and_b32 v251, v209, v63
    s_waitcnt vmcnt(4)
    v_mfma_f32_16x16x32_bf16 v[32:35], v[244:247], v[192:195], v[32:35]
    s_waitcnt vmcnt(3)
    v_mfma_f32_16x16x32_bf16 v[32:35], v[248:251], v[196:199], v[32:35]
    s_lshl_b32 s36, s32, 2
    v_mov_b32 v12, s36
    v_mov_b32 v11, s49
    s_mov_b32 s36, 0x00ff00ff
    s_nop 3
    v_mov_b32_dpp v32, v32 row_ror:8 row_mask:0xc bank_mask:0xf
    v_mov_b32_dpp v33, v33 row_ror:8 row_mask:0xc bank_mask:0xf
    v_mov_b32_dpp v34, v34 row_ror:8 row_mask:0xc bank_mask:0xf
    v_mov_b32_dpp v35, v35 row_ror:8 row_mask:0xc bank_mask:0xf
    s_nop 0
    v_permlane32_swap_b32 v32, v34
    v_permlane32_swap_b32 v33, v35
    v_add_f32 v8, v32, v34
    v_add_f32 v10, v33, v35
    v_cndmask_b32 v10, v10, v27, vcc
    s_mov_b32 exec_lo, s36
    s_mov_b32 exec_hi, s36
    global_store_dwordx4 v26, v[8:11], s[28:29] sc1 nt
    s_mov_b64 exec, -1
    ds_write_b32 v12, v9 offset:16
    s_branch L_streamk
L_notctl:
    s_waitcnt lgkmcnt(0)
    s_load_dword s49, s[28:29], 0
    s_add_u32 s6, s6, s35
    s_addc_u32 s7, s7, 0
    global_load_dwordx4 v[64:67], v4, s[6:7] offset:0 nt
    global_load_dwordx4 v[68:71], v4, s[6:7] offset:128 nt
    global_load_dwordx4 v[72:75], v4, s[6:7] offset:256 nt
    v_add_u32 v4, s33, v4
    s_add_u32 s8, s8, s35
    s_addc_u32 s9, s9, 0
    v_lshlrev_b32 v8, 4, v2
    v_mov_b32 v9, 0xffff
    v_lshlrev_b32 v8, v8, v9
    v_lshrrev_b32 v9, 1, v2
    v_cmp_eq_u32 s[40:41], 0, v9
    v_cmp_eq_u32 s[42:43], 1, v9
    v_cmp_eq_u32 s[44:45], 2, v9
    v_cmp_eq_u32 s[46:47], 3, v9
    v_cndmask_b32 v60, 0, v8, s[40:41]
    v_cndmask_b32 v61, 0, v8, s[42:43]
    v_cndmask_b32 v62, 0, v8, s[44:45]
    v_cndmask_b32 v63, 0, v8, s[46:47]
    s_waitcnt lgkmcnt(0)
    s_mul_i32 s49, s49, 0x9E3779B1
    s_add_u32 s49, s49, 0x7F4A7C15
L_streamk:
L_slot3:
    s_waitcnt vmcnt(2)
    global_load_dwordx4 v[76:79], v4, s[6:7] offset:0 nt
    s_min_u32 s36, s31, 5
    s_cmp_ge_u32 s36, 3
    s_cselect_b32 s50, 1, 0
    s_mul_i32 s51, s50, 3
    s_sub_u32 s51, s36, s51
    v_and_b32 v7, 16, v1
    v_lshl_add_u32 v7, v2, 5, v7
    s_mov_b32 s62, 0x00ff00ff
    s_mov_b32 s63, 0xff00ff00
    s_cmp_eq_u32 s32, 6
    s_cbranch_scc1 L_w2
L_slot4:
    s_waitcnt vmcnt(2)
    global_load_dwordx4 v[80:83], v4, s[6:7] offset:128 nt
L_slot5:
    s_waitcnt vmcnt(2)
    global_load_dwordx4 v[84:87], v4, s[6:7] offset:256 nt
    v_add_u32 v4, s33, v4
L_slot6:
    s_waitcnt vmcnt(2)
    global_load_dwordx4 v[88:91], v4, s[6:7] offset:0 nt
L_slot7:
    s_waitcnt vmcnt(2)
    global_load_dwordx4 v[92:95], v4, s[6:7] offset:128 nt
L_slot8:
    s_waitcnt vmcnt(2)
    global_load_dwordx4 v[96:99], v4, s[6:7] offset:256 nt
    v_add_u32 v4, s33, v4
L_slot9:
    s_waitcnt vmcnt(2)
    global_load_dwordx4 v[100:103], v4, s[6:7] offset:0 nt
    s_and_b32 s36, s32, 6
    s_cmp_eq_u32 s36, 4
    s_cbranch_scc1 L_ga
L_slot10:
    s_waitcnt vmcnt(2)
    global_load_dwordx4 v[104:107], v4, s[6:7] offset:128 nt
L_slot11:
    s_waitcnt vmcnt(2)
    global_load_dwordx4 v[108:111], v4, s[6:7] offset:256 nt
    v_add_u32 v4, s33, v4
L_slot12:
    s_waitcnt vmcnt(2)
    global_load_dwordx4 v[112:115], v4, s[6:7] offset:0 nt
L_slot13:
    s_waitcnt vmcnt(2)
    global_load_dwordx4 v[116:119], v4, s[6:7] offset:128 nt
    s_and_b32 s36, s32, 6
    s_cmp_eq_u32 s36, 4
    s_cbranch_scc1 L_gp
L_slot14:
    s_waitcnt vmcnt(2)
    global_load_dwordx4 v[120:123], v4, s[6:7] offset:256 nt
    v_add_u32 v4, s33, v4
L_slot15:
    s_waitcnt vmcnt(2)
    global_load_dwordx4 v[124:127], v4, s[6:7] offset:0 nt
L_slot16:
    s_waitcnt vmcnt(2)
    global_load_dwordx4 v[128:131], v4, s[6:7] offset:128 nt
L_slot17:
    s_waitcnt vmcnt(2)
    global_load_dwordx4 v[132:135], v4, s[6:7] offset:256 nt
    v_add_u32 v4, s33, v4
L_slot18:
    s_waitcnt vmcnt(2)
    global_load_dwordx4 v[136:139], v4, s[6:7] offset:0 nt
L_slot19:
    s_waitcnt vmcnt(2)
    global_load_dwordx4 v[140:143], v4, s[6:7] offset:128 nt
L_slot20:
    s_waitcnt vmcnt(2)
    global_load_dwordx4 v[144:147], v4, s[6:7] offset:256 nt
    v_add_u32 v4, s33, v4
    s_cmp_eq_u32 s32, 6
    s_cbranch_scc1 L_mc
L_slot21:
    s_waitcnt vmcnt(2)
    global_load_dwordx4 v[148:151], v4, s[6:7] offset:0 nt
L_slot22:
    s_waitcnt vmcnt(2)
    global_load_dwordx4 v[152:155], v4, s[6:7] offset:128 nt
L_slot23:
    s_waitcnt vmcnt(2)
    global_load_dwordx4 v[156:159], v4, s[6:7] offset:256 nt
L_slot24:
    s_waitcnt vmcnt(2)
    global_load_dwordx4 v[160:163], v5, s[8:9] offset:0 nt
L_slot25:
    s_waitcnt vmcnt(2)
    global_load_dwordx4 v[164:167], v5, s[8:9] offset:128 nt
L_slot26:
    s_waitcnt vmcnt(2)
    global_load_dwordx4 v[168:171], v5, s[8:9] offset:256 nt
    v_add_u32 v5, s33, v5
    v_mov_b32 v32, 0
    v_mov_b32 v33, 0
    v_mov_b32 v34, 0
    v_mov_b32 v35, 0
    v_mov_b32 v36, 0
    v_mov_b32 v37, 0
    v_mov_b32 v38, 0
    v_mov_b32 v39, 0
    s_mov_b32 s42, 0xaaaaaaaa
    s_mov_b32 s43, 0xaaaaaaaa
    s_mov_b32 s44, 0xcccccccc
    s_mov_b32 s45, 0xcccccccc
L_slot27:
    s_waitcnt vmcnt(2)
    global_load_dwordx4 v[172:175], v5, s[8:9] offset:0 nt
    s_mov_b32 s39, 2097152
    v_mov_b32 v31, 0
L_wq:
    s_nop 4
    ds_read_b64 v[8:9], v31 offset:0
    s_waitcnt lgkmcnt(0)
    v_readfirstlane_b32 s52, v8
    v_readfirstlane_b32 s36, v9
    s_xor_b32 s52, s52, s49
    s_xor_b32 s36, s36, s49
    s_lshl_b32 s38, s36, 1
    s_or_b32 s36, s36, s38
    s_or_b32 s36, s36, s52
    s_cmp_lt_u32 s36, 2
    s_cbranch_scc1 L_gotq
    s_sleep 2
    s_sub_u32 s39, s39, 1
    s_cmp_lg_u32 s39, 0
    s_cbranch_scc1 L_wq
L_gotq:
    v_lshlrev_b32 v31, 4, v2
    ds_read_b128 v[8:11], v31 offset:64
    ds_read_b128 v[12:15], v31 offset:192
    ds_read_b128 v[16:19], v31 offset:320
    s_waitcnt lgkmcnt(0)
    v_dot2c_f32_bf16 v32, v8, v64
    v_dot2c_f32_bf16 v33, v8, v76
    v_dot2c_f32_bf16 v32, v9, v65
    v_dot2c_f32_bf16 v33, v9, v77
    v_dot2c_f32_bf16 v32, v10, v66
    v_dot2c_f32_bf16 v33, v10, v78
    v_dot2c_f32_bf16 v32, v11, v67
    v_dot2c_f32_bf16 v33, v11, v79
    v_dot2c_f32_bf16 v32, v12, v68
    v_dot2c_f32_bf16 v33, v12, v80
    v_dot2c_f32_bf16 v32, v13, v69
    v_dot2c_f32_bf16 v33, v13, v81
    v_dot2c_f32_bf16 v32, v14, v70
    v_dot2c_f32_bf16 v33, v14, v82
    v_dot2c_f32_bf16 v32, v15, v71
    v_dot2c_f32_bf16 v33, v15, v83
    v_dot2c_f32_bf16 v32, v16, v72
    v_dot2c_f32_bf16 v33, v16, v84
    v_dot2c_f32_bf16 v32, v17, v73
    v_dot2c_f32_bf16 v33, v17, v85
    v_dot2c_f32_bf16 v32, v18, v74
    v_dot2c_f32_bf16 v33, v18, v86
    v_dot2c_f32_bf16 v32, v19, v75
    v_dot2c_f32_bf16 v33, v19, v87
L_slot28:
    s_waitcnt vmcnt(2)
    global_load_dwordx4 v[176:179], v5, s[8:9] offset:128 nt
    v_dot2c_f32_bf16 v34, v8, v88
    v_dot2c_f32_bf16 v35, v8, v100
    v_dot2c_f32_bf16 v36, v8, v112
    v_dot2c_f32_bf16 v34, v9, v89
    v_dot2c_f32_bf16 v35, v9, v101
    v_dot2c_f32_bf16 v36, v9, v113
    v_dot2c_f32_bf16 v34, v10, v90
    v_dot2c_f32_bf16 v35, v10, v102
    v_dot2c_f32_bf16 v36, v10, v114
    v_dot2c_f32_bf16 v34, v11, v91
    v_dot2c_f32_bf16 v35, v11, v103
    v_dot2c_f32_bf16 v36, v11, v115
    v_dot2c_f32_bf16 v34, v12, v92
    v_dot2c_f32_bf16 v35, v12, v104
    v_dot2c_f32_bf16 v36, v12, v116
    v_dot2c_f32_bf16 v34, v13, v93
    v_dot2c_f32_bf16 v35, v13, v105
    v_dot2c_f32_bf16 v36, v13, v117
    v_dot2c_f32_bf16 v34, v14, v94
    v_dot2c_f32_bf16 v35, v14, v106
    v_dot2c_f32_bf16 v36, v14, v118
    v_dot2c_f32_bf16 v34, v15, v95
    v_dot2c_f32_bf16 v35, v15, v107
    v_dot2c_f32_bf16 v36, v15, v119
    v_dot2c_f32_bf16 v34, v16, v96
    v_dot2c_f32_bf16 v35, v16, v108
    v_dot2c_f32_bf16 v36, v16, v120
    v_dot2c_f32_bf16 v34, v17, v97
    v_dot2c_f32_bf16 v35, v17, v109
    v_dot2c_f32_bf16 v36, v17, v121
    v_dot2c_f32_bf16 v34, v18, v98
    v_dot2c_f32_bf16 v35, v18, v110
    v_dot2c_f32_bf16 v36, v18, v122
    v_dot2c_f32_bf16 v34, v19, v99
    v_dot2c_f32_bf16 v35, v19, v111
    v_dot2c_f32_bf16 v36, v19, v123
L_slot29:
    s_waitcnt vmcnt(2)
    global_load_dwordx4 v[180:183], v5, s[8:9] offset:256 nt
    v_add_u32 v5, s33, v5
    v_dot2c_f32_bf16 v37, v8, v124
    v_dot2c_f32_bf16 v38, v8, v136
    v_dot2c_f32_bf16 v39, v8, v148
    v_dot2c_f32_bf16 v37, v9, v125
    v_dot2c_f32_bf16 v38, v9, v137
    v_dot2c_f32_bf16 v39, v9, v149
    v_dot2c_f32_bf16 v37, v10, v126
    v_dot2c_f32_bf16 v38, v10, v138
    v_dot2c_f32_bf16 v39, v10, v150
    v_dot2c_f32_bf16 v37, v11, v127
    v_dot2c_f32_bf16 v38, v11, v139
    v_dot2c_f32_bf16 v39, v11, v151
    v_dot2c_f32_bf16 v37, v12, v128
    v_dot2c_f32_bf16 v38, v12, v140
    v_dot2c_f32_bf16 v39, v12, v152
    v_dot2c_f32_bf16 v37, v13, v129
    v_dot2c_f32_bf16 v38, v13, v141
    v_dot2c_f32_bf16 v39, v13, v153
    v_dot2c_f32_bf16 v37, v14, v130
    v_dot2c_f32_bf16 v38, v14, v142
    v_dot2c_f32_bf16 v39, v14, v154
    v_dot2c_f32_bf16 v37, v15, v131
    v_dot2c_f32_bf16 v38, v15, v143
    v_dot2c_f32_bf16 v39, v15, v155
    v_dot2c_f32_bf16 v37, v16, v132
    v_dot2c_f32_bf16 v38, v16, v144
    v_dot2c_f32_bf16 v39, v16, v156
    v_dot2c_f32_bf16 v37, v17, v133
    v_dot2c_f32_bf16 v38, v17, v145
    v_dot2c_f32_bf16 v39, v17, v157
    v_dot2c_f32_bf16 v37, v18, v134
    v_dot2c_f32_bf16 v38, v18, v146
    v_dot2c_f32_bf16 v39, v18, v158
    v_dot2c_f32_bf16 v37, v19, v135
    v_dot2c_f32_bf16 v38, v19, v147
    v_dot2c_f32_bf16 v39, v19, v159
L_slot30:
    s_waitcnt vmcnt(2)
    global_load_dwordx4 v[184:187], v5, s[8:9] offset:0 nt
    v_add_f32_dpp v32, v32, v32 row_shl:4 row_mask:0xf bank_mask:0x5
    v_add_f32_dpp v33, v33, v33 row_shl:4 row_mask:0xf bank_mask:0x5
    v_add_f32_dpp v34, v34, v34 row_shl:4 row_mask:0xf bank_mask:0x5
    v_add_f32_dpp v35, v35, v35 row_shl:4 row_mask:0xf bank_mask:0x5
    v_add_f32_dpp v32, v36, v36 row_shr:4 row_mask:0xf bank_mask:0xa
    v_add_f32_dpp v33, v37, v37 row_shr:4 row_mask:0xf bank_mask:0xa
    v_add_f32_dpp v34, v38, v38 row_shr:4 row_mask:0xf bank_mask:0xa
    v_add_f32_dpp v35, v39, v39 row_shr:4 row_mask:0xf bank_mask:0xa
    v_add_f32_dpp v32, v32, v32 quad_perm:[2,3,0,1] row_mask:0xf bank_mask:0xf
    v_add_f32_dpp v33, v33, v33 quad_perm:[2,3,0,1] row_mask:0xf bank_mask:0xf
    v_add_f32_dpp v34, v34, v34 quad_perm:[2,3,0,1] row_mask:0xf bank_mask:0xf
    v_add_f32_dpp v35, v35, v35 quad_perm:[2,3,0,1] row_mask:0xf bank_mask:0xf
    v_cndmask_b32 v32, v32, v34, s[44:45]
    v_cndmask_b32 v33, v33, v35, s[44:45]
    s_nop 0
    v_add_f32_dpp v32, v32, v32 quad_perm:[1,0,3,2] row_mask:0xf bank_mask:0xf
    v_add_f32_dpp v33, v33, v33 quad_perm:[1,0,3,2] row_mask:0xf bank_mask:0xf
    v_cndmask_b32 v32, v32, v33, s[42:43]
    v_cvt_pk_bf16_f32 v32, 0, v32
    v_mul_f32 v32, 0x3d93cd3a, v32
    v_cvt_pk_bf16_f32 v32, 0, v32
    v_mul_f32 v32, 0x3fb8aa3b, v32
    v_mov_b32 v33, v32
    s_nop 1
    v_max_f32_dpp v33, v33, v33 row_shr:1 row_mask:0xf bank_mask:0xf
    s_nop 1
    v_max_f32_dpp v33, v33, v33 row_shr:2 row_mask:0xf bank_mask:0xf
    s_nop 1
    v_max_f32_dpp v33, v33, v33 row_shr:4 row_mask:0xf bank_mask:0xf
    s_nop 1
    v_max_f32_dpp v33, v33, v33 row_shr:8 row_mask:0xf bank_mask:0xf
    s_nop 1
    v_max_f32_dpp v33, v33, v33 row_bcast:15 row_mask:0xa bank_mask:0xf
    s_nop 1
    v_max_f32_dpp v33, v33, v33 row_bcast:31 row_mask:0xc bank_mask:0xf
    s_nop 0
    v_readlane_b32 s46, v33, 63
L_slot31:
    s_waitcnt vmcnt(2)
    global_load_dwordx4 v[188:191], v5, s[8:9] offset:128 nt
    v_subrev_f32 v32, s46, v32
    v_exp_f32 v32, v32
    s_nop 0
    v_mov_b32 v33, v32
    v_cvt_pk_bf16_f32 v34, v32, v32
    s_nop 1
    v_mov_b32_dpp v8, v34 row_newbcast:0 row_mask:0xf bank_mask:0x3
    v_mov_b32_dpp v8, v34 row_newbcast:8 row_mask:0xf bank_mask:0xc
    v_add_f32_dpp v33, v33, v33 row_shr:1 row_mask:0xf bank_mask:0xf
    v_mov_b32_dpp v9, v34 row_newbcast:1 row_mask:0xf bank_mask:0x3
    v_mov_b32_dpp v9, v34 row_newbcast:9 row_mask:0xf bank_mask:0xc
    v_add_f32_dpp v33, v33, v33 row_shr:2 row_mask:0xf bank_mask:0xf
    v_mov_b32_dpp v10, v34 row_newbcast:2 row_mask:0xf bank_mask:0x3
    v_mov_b32_dpp v10, v34 row_newbcast:10 row_mask:0xf bank_mask:0xc
    v_add_f32_dpp v33, v33, v33 row_shr:4 row_mask:0xf bank_mask:0xf
    v_mov_b32_dpp v11, v34 row_newbcast:3 row_mask:0xf bank_mask:0x3
    v_mov_b32_dpp v11, v34 row_newbcast:11 row_mask:0xf bank_mask:0xc
    v_add_f32_dpp v33, v33, v33 row_shr:8 row_mask:0xf bank_mask:0xf
    v_mov_b32_dpp v12, v34 row_newbcast:4 row_mask:0xf bank_mask:0x3
    v_mov_b32_dpp v12, v34 row_newbcast:12 row_mask:0xf bank_mask:0xc
    v_add_f32_dpp v33, v33, v33 row_bcast:15 row_mask:0xa bank_mask:0xf
    v_mov_b32_dpp v13, v34 row_newbcast:5 row_mask:0xf bank_mask:0x3
    v_mov_b32_dpp v13, v34 row_newbcast:13 row_mask:0xf bank_mask:0xc
    v_add_f32_dpp v33, v33, v33 row_bcast:31 row_mask:0xc bank_mask:0xf
    v_mov_b32_dpp v14, v34 row_newbcast:6 row_mask:0xf bank_mask:0x3
    v_mov_b32_dpp v14, v34 row_newbcast:14 row_mask:0xf bank_mask:0xc
    v_mov_b32_dpp v15, v34 row_newbcast:7 row_mask:0xf bank_mask:0x3
    v_mov_b32_dpp v15, v34 row_newbcast:15 row_mask:0xf bank_mask:0xc
    v_readlane_b32 s47, v33, 63
L_slot32:
    s_waitcnt vmcnt(2)
    global_load_dwordx4 v[192:195], v5, s[8:9] offset:256 nt
    v_add_u32 v5, s33, v5
    v_and_b32 v64, v8, v60
    v_and_b32 v65, v8, v61
    v_and_b32 v66, v8, v62
    v_and_b32 v67, v8, v63
    v_and_b32 v68, v9, v60
    v_and_b32 v69, v9, v61
    v_and_b32 v70, v9, v62
    v_and_b32 v71, v9, v63
    v_and_b32 v72, v10, v60
    v_and_b32 v73, v10, v61
    v_and_b32 v74, v10, v62
    v_and_b32 v75, v10, v63
    v_and_b32 v76, v11, v60
    v_and_b32 v77, v11, v61
    v_and_b32 v78, v11, v62
    v_and_b32 v79, v11, v63
    v_and_b32 v80, v12, v60
    v_and_b32 v81, v12, v61
    v_and_b32 v82, v12, v62
    v_and_b32 v83, v12, v63
    v_and_b32 v84, v13, v60
    v_and_b32 v85, v13, v61
    v_and_b32 v86, v13, v62
    v_and_b32 v87, v13, v63
    v_and_b32 v88, v14, v60
    v_and_b32 v89, v14, v61
    v_and_b32 v90, v14, v62
    v_and_b32 v91, v14, v63
    v_and_b32 v92, v15, v60
    v_and_b32 v93, v15, v61
    v_and_b32 v94, v15, v62
    v_and_b32 v95, v15, v63
L_slot33:
    s_waitcnt vmcnt(2)
    global_load_dwordx4 v[196:199], v5, s[8:9] offset:0 nt
    s_mul_i32 s36, s30, 245760
    s_mul_i32 s38, s32, 30720
    s_add_u32 s36, s36, s38
    v_mul_u32_u24 v24, 3840, v3
    v_lshl_add_u32 v24, v2, 4, v24
    v_add_u32 v24, s36, v24
    s_mul_i32 s36, s51, 1280
    s_lshl_b32 s38, s50, 7
    s_add_u32 s36, s36, s38
    s_add_u32 s36, s36, 1024
    v_add_u32 v25, s36, v24
    s_lshl_b32 s38, s31, 7
    v_add_u32 v24, s38, v24
    v_mov_b32 v26, s46
    v_mov_b32 v27, s47
    s_lshl_b32 s36, s32, 3
    v_mov_b32 v30, s36
    ds_write_b64 v30, v[26:27] offset:640
    v_lshrrev_b32 v30, 5, v1
    s_mul_i32 s36, s32, 1536
    v_mul_u32_u24 v31, 768, v30
    v_add3_u32 v31, v31, v7, s36
    s_lshl_b32 s36, s32, 10
    v_lshl_add_u32 v124, v30, 8, v7
    v_add_u32 v124, s36, v124
    v_mfma_f32_16x16x32_bf16 v[40:43], v[64:67], v[160:163], 0
    v_mfma_f32_16x16x32_bf16 v[44:47], v[64:67], v[164:167], 0
    v_mfma_f32_16x16x32_bf16 v[48:51], v[64:67], v[168:171], 0
L_slot34:
    s_waitcnt vmcnt(2)
    global_load_dwordx4 v[200:203], v5, s[8:9] offset:128 nt
    v_mfma_f32_16x16x32_bf16 v[40:43], v[68:71], v[172:175], v[40:43]
    v_mfma_f32_16x16x32_bf16 v[44:47], v[68:71], v[176:179], v[44:47]
    v_mfma_f32_16x16x32_bf16 v[48:51], v[68:71], v[180:183], v[48:51]
L_slot35:
    s_waitcnt vmcnt(2)
    global_load_dwordx4 v[204:207], v5, s[8:9] offset:256 nt
    v_add_u32 v5, s33, v5
    s_lshl_b32 s48, s34, 11
    s_lshl_b32 s36, s30, 14
    s_lshl_b32 s38, s32, 11
    s_add_u32 s36, s36, s38
    s_add_u32 s36, s36, 1048576
    v_lshl_add_u32 v28, v1, 4, s36
    v_min_u32 v30, 32, v1
    v_lshl_add_u32 v29, v30, 4, s36
    s_mul_i32 s36, s32, 816
    s_add_u32 s36, s36, 22272
    v_lshl_add_u32 v120, v1, 3, s36
    v_lshl_add_u32 v121, v30, 3, s36
    v_mul_u32_u24 v122, 816, v2
    v_mul_u32_u24 v123, 12, v3
    s_mul_i32 s36, s32, 96
    v_add3_u32 v123, v123, v122, s36
    s_cmp_eq_u32 s51, 1
    s_cselect_b64 s[54:55], -1, 0
    s_cmp_eq_u32 s51, 2
    s_cselect_b64 s[56:57], -1, 0
    v_min_u32 v22, 191, v0
    v_lshlrev_b32 v22, 2, v22
    s_add_u32 s36, s48, 1048576
    v_lshl_add_u32 v23, v22, 1, s36
    v_mov_b32 v21, 0
    v_mfma_f32_16x16x32_bf16 v[40:43], v[72:75], v[184:187], v[40:43]
    v_mfma_f32_16x16x32_bf16 v[44:47], v[72:75], v[188:191], v[44:47]
    v_mfma_f32_16x16x32_bf16 v[48:51], v[72:75], v[192:195], v[48:51]
L_slot36:
    s_waitcnt vmcnt(2)
    global_load_dwordx4 v[208:211], v5, s[8:9] offset:0 nt
    v_mfma_f32_16x16x32_bf16 v[40:43], v[76:79], v[196:199], v[40:43]
L_slot37:
    s_waitcnt vmcnt(2)
    global_load_dwordx4 v[212:215], v5, s[8:9] offset:128 nt
    s_and_b32 s58, s2, 7
    s_mul_i32 s58, s58, 20
    s_lshr_b32 s36, s2, 3
    s_min_u32 s36, s36, 19
    s_add_u32 s58, s58, s36
    v_lshrrev_b32 v129, 1, v1
    v_mul_u32_u24 v129, 7168, v129
    v_and_b32 v30, 1, v1
    v_lshl_add_u32 v129, v30, 4, v129
    s_lshl_b32 s36, s58, 5
    s_add_u32 s36, s36, 1572864
    v_add_u32 v129, s36, v129
    v_add_u32 v125, 262144, v129
    v_bfe_u32 v128, v1, 2, 1
    v_lshl_add_u32 v128, v30, 1, v128
    s_lshl_b32 s36, s58, 2
    v_add_u32 v128, s36, v128
    v_lshlrev_b32 v128, 1, v128
    v_mov_b32 v136, 0
    v_mov_b32 v137, s49
    v_mov_b32 v138, 0
    v_mov_b32 v139, s49
    v_mov_b32 v140, 0
    v_mov_b32 v141, s49
    v_mov_b32 v142, 0
    v_mov_b32 v143, s49
    v_mov_b32 v148, 0
    v_mov_b32 v149, s49
    v_mov_b32 v150, 0
    v_mov_b32 v151, s49
    v_mov_b32 v152, 0
    v_mov_b32 v153, s49
    v_mov_b32 v154, 0
    v_mov_b32 v155, s49
    v_mfma_f32_16x16x32_bf16 v[44:47], v[76:79], v[200:203], v[44:47]
L_slot38:
    s_waitcnt vmcnt(2)
    global_load_dwordx4 v[216:219], v5, s[8:9] offset:256 nt
    v_add_u32 v5, s33, v5
    v_mfma_f32_16x16x32_bf16 v[48:51], v[76:79], v[204:207], v[48:51]
L_slot39:
    s_waitcnt vmcnt(2)
    global_load_dwordx4 v[220:223], v5, s[8:9] offset:0 nt
    s_mul_i32 s59, s30, 7168
    s_lshl_b32 s38, s31, 9
    s_add_u32 s59, s59, s38
    s_add_u32 s59, s59, 1572864
    s_mul_i32 s60, s30, 7168
    s_lshl_b32 s38, s51, 10
    s_add_u32 s60, s60, s38
    s_lshl_b32 s38, s50, 9
    s_add_u32 s60, s60, s38
    s_add_u32 s60, s60, 1576960
    s_bitcmp1_b32 s32, 0
    s_cselect_b32 s59, s60, s59
    v_lshl_add_u32 v126, v1, 3, s59
    v_lshlrev_b32 v127, 2, v1
    s_and_b32 s36, s32, 1
    s_lshl_b32 s36, s36, 9
    v_add_u32 v127, s36, v127
    v_mov_b32 v157, s49
    v_mfma_f32_16x16x32_bf16 v[40:43], v[80:83], v[208:211], v[40:43]
L_slot40:
    s_waitcnt vmcnt(2)
    global_load_dwordx4 v[224:227], v5, s[8:9] offset:128 nt
    v_mfma_f32_16x16x32_bf16 v[44:47], v[80:83], v[212:215], v[44:47]
L_slot41:
    s_waitcnt vmcnt(2)
    global_load_dwordx4 v[228:231], v5, s[8:9] offset:256 nt
    v_add_u32 v5, s33, v5
    v_mfma_f32_16x16x32_bf16 v[48:51], v[80:83], v[216:219], v[48:51]
L_slot42:
    s_waitcnt vmcnt(2)
    global_load_dwordx4 v[232:235], v5, s[8:9] offset:0 nt
    v_mfma_f32_16x16x32_bf16 v[40:43], v[84:87], v[220:223], v[40:43]
L_slot43:
    s_waitcnt vmcnt(2)
    global_load_dwordx4 v[236:239], v5, s[8:9] offset:128 nt
    v_mfma_f32_16x16x32_bf16 v[44:47], v[84:87], v[224:227], v[44:47]
L_slot44:
    s_waitcnt vmcnt(2)
    global_load_dwordx4 v[240:243], v5, s[8:9] offset:256 nt
    v_add_u32 v5, s33, v5
    v_mfma_f32_16x16x32_bf16 v[48:51], v[84:87], v[228:231], v[48:51]
L_slot45:
    s_waitcnt vmcnt(2)
    global_load_dwordx4 v[244:247], v5, s[8:9] offset:0 nt
    v_mfma_f32_16x16x32_bf16 v[40:43], v[88:91], v[232:235], v[40:43]
L_slot46:
    s_waitcnt vmcnt(2)
    global_load_dwordx4 v[248:251], v5, s[8:9] offset:128 nt
    v_mfma_f32_16x16x32_bf16 v[44:47], v[88:91], v[236:239], v[44:47]
L_slot47:
    s_waitcnt vmcnt(2)
    global_load_dwordx4 v[252:255], v5, s[8:9] offset:256 nt
    v_mfma_f32_16x16x32_bf16 v[48:51], v[88:91], v[240:243], v[48:51]
    s_waitcnt vmcnt(2)
    v_mfma_f32_16x16x32_bf16 v[40:43], v[92:95], v[244:247], v[40:43]
    s_waitcnt vmcnt(1)
    v_mfma_f32_16x16x32_bf16 v[44:47], v[92:95], v[248:251], v[44:47]
    s_waitcnt vmcnt(0)
    v_mfma_f32_16x16x32_bf16 v[48:51], v[92:95], v[252:255], v[48:51]
    global_load_dwordx4 v[96:99], v24, s[12:13] offset:0 nt
    global_load_dwordx4 v[100:103], v24, s[12:13] offset:1280 nt
    global_load_dwordx4 v[104:107], v24, s[12:13] offset:2560 nt
    s_cmp_ge_u32 s31, 6
    s_cbranch_scc1 L_noex
    global_load_dwordx4 v[108:111], v25, s[12:13] nt
L_noex:
    s_mov_b64 exec, s[62:63]
    ds_write_b128 v31, v[40:43] offset:1792
    ds_write_b128 v31, v[44:47] offset:2048
    ds_write_b128 v31, v[48:51] offset:2304
    s_mov_b64 exec, -1
    s_waitcnt lgkmcnt(0)
    s_barrier
    s_cmp_ge_u32 s32, 4
    s_cbranch_scc1 L_mpub
    ds_read_b128 v[64:67], v21 offset:640
    ds_read_b128 v[68:71], v21 offset:656
    ds_read_b128 v[72:75], v21 offset:672
    ds_read_b128 v[76:79], v21 offset:688
    ds_read2st64_b32 v[32:33], v22 offset0:7 offset1:10
    ds_read2st64_b32 v[34:35], v22 offset0:13 offset1:16
    ds_read2st64_b32 v[36:37], v22 offset0:19 offset1:22
    ds_read2st64_b32 v[38:39], v22 offset0:25 offset1:28
    ds_read2st64_b32 v[40:41], v22 offset0:31 offset1:34
    ds_read2st64_b32 v[42:43], v22 offset0:37 offset1:40
    ds_read2st64_b32 v[44:45], v22 offset0:43 offset1:46
    ds_read2st64_b32 v[46:47], v22 offset0:49 offset1:52
    s_waitcnt lgkmcnt(8)
    v_max3_f32 v24, v64, v66, v68
    v_max3_f32 v25, v70, v72, v74
    v_max3_f32 v24, v24, v76, v78
    v_max_f32 v24, v24, v25
    v_sub_f32 v64, v64, v24
    v_sub_f32 v66, v66, v24
    v_sub_f32 v68, v68, v24
    v_sub_f32 v70, v70, v24
    v_sub_f32 v72, v72, v24
    v_sub_f32 v74, v74, v24
    v_sub_f32 v76, v76, v24
    v_sub_f32 v78, v78, v24
    v_exp_f32 v64, v64
    v_exp_f32 v66, v66
    v_exp_f32 v68, v68
    v_exp_f32 v70, v70
    v_exp_f32 v72, v72
    v_exp_f32 v74, v74
    v_exp_f32 v76, v76
    v_exp_f32 v78, v78
    s_cmp_eq_u32 s32, 3
    s_cbranch_scc1 L_mlpub
    s_waitcnt lgkmcnt(0)
    v_add_f32 v32, v32, v33
    v_add_f32 v34, v34, v35
    v_add_f32 v36, v36, v37
    v_add_f32 v38, v38, v39
    v_add_f32 v40, v40, v41
    v_add_f32 v42, v42, v43
    v_add_f32 v44, v44, v45
    v_add_f32 v46, v46, v47
    v_mul_f32 v26, v64, v32
    v_mul_f32 v27, v66, v34
    v_fmac_f32 v26, v68, v36
    v_fmac_f32 v27, v70, v38
    v_fmac_f32 v26, v72, v40
    v_fmac_f32 v27, v74, v42
    v_fmac_f32 v26, v76, v44
    v_fmac_f32 v27, v78, v46
    v_add_f32 v156, v26, v27
    s_cmp_eq_u32 s52, 1
    s_cbranch_scc0 L_opub_far
    global_store_dwordx2 v23, v[156:157], s[28:29]
    s_branch L_hop1
L_opub_far:
    global_store_dwordx2 v23, v[156:157], s[28:29] sc1
    s_branch L_hop1
L_mlpub:
    v_mul_f32 v26, v64, v65
    v_mul_f32 v27, v66, v67
    v_fmac_f32 v26, v68, v69
    v_fmac_f32 v27, v70, v71
    v_fmac_f32 v26, v72, v73
    v_fmac_f32 v27, v74, v75
    v_fmac_f32 v26, v76, v77
    v_fmac_f32 v27, v78, v79
    v_add_f32 v26, v26, v27
    v_mov_b32 v25, s49
    v_mov_b32 v27, s49
    s_add_u32 s36, s48, 1050112
    v_lshl_add_u32 v30, v1, 4, s36
    s_mov_b64 exec, 0xff
    s_cmp_eq_u32 s52, 1
    s_cbranch_scc0 L_mlpub_far
    global_store_dwordx4 v30, v[24:27], s[28:29]
    s_mov_b64 exec, -1
    s_branch L_hop1
L_mlpub_far:
    global_store_dwordx4 v30, v[24:27], s[28:29] sc1
    s_mov_b64 exec, -1
    s_branch L_hop1
L_mpub:
    s_cmp_ge_u32 s31, 6
    s_cselect_b32 s36, 5, 6
    s_cmp_ge_u32 s32, s36
    s_cbranch_scc1 L_hop1
    ds_read2st64_b32 v[32:33], v127 offset0:3 offset1:4
    v_add_u32 v30, 262144, v126
    s_waitcnt lgkmcnt(0)
    v_add_f32 v156, v32, v33
    global_store_dwordx2 v30, v[156:157], s[28:29] sc1
L_hop1:
    s_mov_b32 s39, 2097152
L_h1:
    global_load_dwordx4 v[52:55], v28, s[28:29] sc1
    global_load_dwordx4 v[56:59], v29, s[28:29] offset:1024 sc1
    s_waitcnt vmcnt(0)
    v_xor_b32 v20, s49, v53
    v_bitop3_b32 v20, v55, v20, s49 bitop3:0xde
    v_bitop3_b32 v20, v57, v20, s49 bitop3:0xde
    v_bitop3_b32 v20, v59, v20, s49 bitop3:0xde
    v_cmp_eq_u32 vcc, 0, v20
    s_nop 0
    s_cmp_eq_u64 vcc, exec
    s_cbranch_scc1 L_h1ok
    s_sub_u32 s39, s39, 1
    s_cmp_lg_u32 s39, 0
    s_cbranch_scc1 L_h1
L_h1ok:
    ds_write2_b32 v120, v52, v54 offset0:0 offset1:1
    ds_write2_b32 v121, v56, v58 offset0:128 offset1:129
    s_waitcnt lgkmcnt(0)
    s_barrier
    ds_read_b64 v[16:17], v122 offset:23040
    ds_read_b32 v8, v123 offset:22272
    ds_read_b32 v9, v123 offset:22276
    ds_read_b32 v10, v123 offset:22280
    s_cmp_lg_u32 s32, 7
    s_cbranch_scc1 L_nomg
    s_cmp_ge_u32 s2, 160
    s_cbranch_scc1 L_nomg
    global_load_ushort v130, v128, s[4:5]
    global_load_ushort v131, v128, s[22:23]
    global_load_dwordx4 v[132:135], v125, s[28:29] sc0 sc1
    s_cmp_lt_u32 s58, 128
    s_cbranch_scc1 L_nomg
    global_load_dwordx4 v[136:139], v125, s[28:29] offset:1024 sc0 sc1
    global_load_dwordx4 v[140:143], v125, s[28:29] offset:2048 sc0 sc1
L_nomg:
    s_waitcnt lgkmcnt(3)
    v_max_f32_dpp v20, v16, v16 quad_perm:[1,0,3,2] row_mask:0xf bank_mask:0xf
    s_nop 1
    v_max_f32_dpp v20, v20, v20 quad_perm:[2,3,0,1] row_mask:0xf bank_mask:0xf
    s_nop 1
    v_max_f32_dpp v20, v20, v20 row_half_mirror row_mask:0xf bank_mask:0xf
    v_sub_f32 v16, v16, v20
    v_exp_f32 v16, v16
    s_waitcnt lgkmcnt(0)
    v_mul_f32 v17, v17, v16
    v_mul_f32 v8, v8, v16
    v_mul_f32 v9, v9, v16
    v_mul_f32 v10, v10, v16
    v_add_f32_dpp v17, v17, v17 quad_perm:[1,0,3,2] row_mask:0xf bank_mask:0xf
    v_add_f32_dpp v8, v8, v8 quad_perm:[1,0,3,2] row_mask:0xf bank_mask:0xf
    v_add_f32_dpp v9, v9, v9 quad_perm:[1,0,3,2] row_mask:0xf bank_mask:0xf
    v_add_f32_dpp v10, v10, v10 quad_perm:[1,0,3,2] row_mask:0xf bank_mask:0xf
    v_add_f32_dpp v17, v17, v17 quad_perm:[2,3,0,1] row_mask:0xf bank_mask:0xf
    v_add_f32_dpp v8, v8, v8 quad_perm:[2,3,0,1] row_mask:0xf bank_mask:0xf
    v_add_f32_dpp v9, v9, v9 quad_perm:[2,3,0,1] row_mask:0xf bank_mask:0xf
    v_add_f32_dpp v10, v10, v10 quad_perm:[2,3,0,1] row_mask:0xf bank_mask:0xf
    v_add_f32_dpp v17, v17, v17 row_half_mirror row_mask:0xf bank_mask:0xf
    v_add_f32_dpp v8, v8, v8 row_half_mirror row_mask:0xf bank_mask:0xf
    v_add_f32_dpp v9, v9, v9 row_half_mirror row_mask:0xf bank_mask:0xf
    v_add_f32_dpp v10, v10, v10 row_half_mirror row_mask:0xf bank_mask:0xf
    v_rcp_f32 v17, v17
    s_nop 0
    v_mul_f32 v8, v8, v17
    v_mul_f32 v9, v9, v17
    v_mul_f32 v10, v10, v17
    v_cvt_pk_bf16_f32 v8, v8, v8
    v_cvt_pk_bf16_f32 v9, v9, v9
    v_cvt_pk_bf16_f32 v10, v10, v10
    v_and_b32 v64, v8, v60
    v_and_b32 v65, v8, v61
    v_and_b32 v66, v8, v62
    v_and_b32 v67, v8, v63
    v_cndmask_b32 v11, v8, v9, s[54:55]
    v_and_b32 v68, v9, v60
    v_and_b32 v69, v9, v61
    v_and_b32 v70, v9, v62
    v_and_b32 v71, v9, v63
    v_mfma_f32_16x16x32_bf16 v[112:115], v[64:67], v[96:99], 0
    v_cndmask_b32 v11, v11, v10, s[56:57]
    v_and_b32 v72, v10, v60
    v_and_b32 v73, v10, v61
    v_and_b32 v74, v10, v62
    v_and_b32 v75, v10, v63
    v_mfma_f32_16x16x32_bf16 v[112:115], v[68:71], v[100:103], v[112:115]
    v_and_b32 v76, v11, v60
    v_and_b32 v77, v11, v61
    v_and_b32 v78, v11, v62
    v_and_b32 v79, v11, v63
    v_mfma_f32_16x16x32_bf16 v[112:115], v[72:75], v[104:107], v[112:115]
    s_nop 0
    v_mfma_f32_16x16x32_bf16 v[116:119], v[76:79], v[108:111], 0
    s_mov_b64 exec, s[62:63]
    s_nop 4
    ds_write_b128 v124, v[112:115] offset:14080
    s_nop 0
    ds_write_b128 v124, v[116:119] offset:14592
    s_mov_b64 exec, -1
    s_waitcnt lgkmcnt(0)
    s_barrier
    s_cmp_eq_u32 s32, 7
    s_cbranch_scc1 L_final
    s_cmp_ge_u32 s31, 6
    s_cselect_b32 s36, 1, 2
    s_cmp_ge_u32 s32, s36
    s_cbranch_scc1 L_done
    ds_read2st64_b32 v[32:33], v127 offset0:55 offset1:56
    ds_read2st64_b32 v[34:35], v127 offset0:59 offset1:60
    ds_read2st64_b32 v[36:37], v127 offset0:63 offset1:64
    ds_read2st64_b32 v[38:39], v127 offset0:67 offset1:68
    ds_read2st64_b32 v[40:41], v127 offset0:71 offset1:72
    ds_read2st64_b32 v[42:43], v127 offset0:75 offset1:76
    ds_read2st64_b32 v[44:45], v127 offset0:79 offset1:80
    ds_read2st64_b32 v[46:47], v127 offset0:83 offset1:84
    s_waitcnt lgkmcnt(6)
    v_add_f32 v32, v32, v33
    v_add_f32 v34, v34, v35
    s_waitcnt lgkmcnt(4)
    v_add_f32 v36, v36, v37
    v_add_f32 v38, v38, v39
    s_waitcnt lgkmcnt(2)
    v_add_f32 v40, v40, v41
    v_add_f32 v42, v42, v43
    s_waitcnt lgkmcnt(0)
    v_add_f32 v44, v44, v45
    v_add_f32 v46, v46, v47
    v_add_f32 v32, v32, v34
    v_add_f32 v36, v36, v38
    v_add_f32 v40, v40, v42
    v_add_f32 v44, v44, v46
    v_add_f32 v32, v32, v36
    v_add_f32 v40, v40, v44
    v_add_f32 v156, v32, v40
    global_store_dwordx2 v126, v[156:157], s[28:29] sc0 sc1
    s_branch L_done
L_final:
    s_cmp_ge_u32 s2, 160
    s_cbranch_scc1 L_done
    s_mov_b32 s39, 2097152
    s_branch L_pmw
L_pm:
    global_load_dwordx4 v[132:135], v125, s[28:29] sc0 sc1
    s_cmp_lt_u32 s58, 128
    s_cbranch_scc1 L_pmw
    global_load_dwordx4 v[136:139], v125, s[28:29] offset:1024 sc0 sc1
    global_load_dwordx4 v[140:143], v125, s[28:29] offset:2048 sc0 sc1
L_pmw:
    s_waitcnt vmcnt(0)
L_pmc:
    v_xor_b32 v14, s49, v133
    v_bitop3_b32 v14, v135, v14, s49 bitop3:0xde
    v_bitop3_b32 v14, v137, v14, s49 bitop3:0xde
    v_bitop3_b32 v14, v139, v14, s49 bitop3:0xde
    v_bitop3_b32 v14, v141, v14, s49 bitop3:0xde
    v_bitop3_b32 v14, v143, v14, s49 bitop3:0xde
    v_cmp_eq_u32 vcc, 0, v14
    s_nop 0
    s_cmp_eq_u64 vcc, exec
    s_cbranch_scc1 L_pmok
    s_sub_u32 s39, s39, 1
    s_cmp_lg_u32 s39, 0
    s_cbranch_scc1 L_pm
L_pmok:
    global_load_dwordx4 v[144:147], v129, s[28:29] sc0 sc1
    s_cmp_lt_u32 s58, 128
    s_cbranch_scc1 L_ps0
    global_load_dwordx4 v[148:151], v129, s[28:29] offset:1024 sc0 sc1
    global_load_dwordx4 v[152:155], v129, s[28:29] offset:2048 sc0 sc1
L_ps0:
    v_add_f32 v136, v136, v140
    v_add_f32 v138, v138, v142
    v_add_f32 v132, v132, v136
    v_add_f32 v134, v134, v138
    s_nop 0
    v_add_f32_dpp v132, v132, v132 row_shl:4 row_mask:0xf bank_mask:0x5
    v_add_f32_dpp v132, v134, v134 row_shr:4 row_mask:0xf bank_mask:0xa
    s_nop 1
    v_add_f32_dpp v132, v132, v132 row_ror:8 row_mask:0xf bank_mask:0xf
    s_nop 1
    v_add_f32_dpp v132, v132, v132 quad_perm:[2,3,0,1] row_mask:0xf bank_mask:0xf
    v_mov_b32 v133, v132
    s_nop 1
    v_permlane16_swap_b32 v132, v133
    v_add_f32 v132, v132, v133
    v_mov_b32 v133, v132
    s_nop 1
    v_permlane32_swap_b32 v132, v133
    v_add_f32 v132, v132, v133
    v_lshlrev_b32 v131, 16, v131
    v_lshlrev_b32 v130, 16, v130
    v_cvt_pk_bf16_f32 v8, 0, v132
    v_add_f32 v8, v8, v131
    v_cvt_pk_bf16_f32 v8, 0, v8
    v_mul_f32 v9, 0xbfb8aa3b, v8
    v_exp_f32 v9, v9
    s_nop 0
    v_add_f32 v9, 1.0, v9
    v_rcp_f32 v9, v9
    s_nop 0
    v_mul_f32 v8, v8, v9
    v_cvt_pk_bf16_f32 v131, 0, v8
    s_mov_b32 s39, 2097152
    s_branch L_psw
L_ps:
    global_load_dwordx4 v[144:147], v129, s[28:29] sc0 sc1
    s_cmp_lt_u32 s58, 128
    s_cbranch_scc1 L_psw
    global_load_dwordx4 v[148:151], v129, s[28:29] offset:1024 sc0 sc1
    global_load_dwordx4 v[152:155], v129, s[28:29] offset:2048 sc0 sc1
L_psw:
    s_waitcnt vmcnt(0)
    v_xor_b32 v14, s49, v145
    v_bitop3_b32 v14, v147, v14, s49 bitop3:0xde
    v_bitop3_b32 v14, v149, v14, s49 bitop3:0xde
    v_bitop3_b32 v14, v151, v14, s49 bitop3:0xde
    v_bitop3_b32 v14, v153, v14, s49 bitop3:0xde
    v_bitop3_b32 v14, v155, v14, s49 bitop3:0xde
    v_cmp_eq_u32 vcc, 0, v14
    s_nop 0
    s_cmp_eq_u64 vcc, exec
    s_cbranch_scc1 L_psok
    s_sub_u32 s39, s39, 1
    s_cmp_lg_u32 s39, 0
    s_cbranch_scc1 L_ps
L_psok:
    v_add_f32 v148, v148, v152
    v_add_f32 v150, v150, v154
    v_add_f32 v144, v144, v148
    v_add_f32 v146, v146, v150
    s_nop 0
    v_add_f32_dpp v144, v144, v144 row_shl:4 row_mask:0xf bank_mask:0x5
    v_add_f32_dpp v144, v146, v146 row_shr:4 row_mask:0xf bank_mask:0xa
    s_nop 1
    v_add_f32_dpp v144, v144, v144 row_ror:8 row_mask:0xf bank_mask:0xf
    s_nop 1
    v_add_f32_dpp v144, v144, v144 quad_perm:[2,3,0,1] row_mask:0xf bank_mask:0xf
    v_mov_b32 v145, v144
    s_nop 1
    v_permlane16_swap_b32 v144, v145
    v_add_f32 v144, v144, v145
    v_mov_b32 v145, v144
    s_nop 1
    v_permlane32_swap_b32 v144, v145
    v_add_f32 v144, v144, v145
    v_cvt_pk_bf16_f32 v16, 0, v144
    v_mul_f32 v16, v16, v131
    v_cvt_pk_bf16_f32 v16, 0, v16
    v_add_f32 v16, v130, v16
    v_cvt_pk_bf16_f32 v16, v16, v16
    s_mov_b64 exec, 0x33
    global_store_short v128, v16, s[24:25]
    s_cmp_lg_u32 s2, 0
    s_cbranch_scc1 L_done2
    s_mov_b64 exec, 1
    v_mov_b32 v18, 0
    global_store_dword v18, v157, s[28:29]
L_done2:
    s_mov_b64 exec, -1
L_done:
L_end:
    s_endpgm
L_w2:
    s_mul_i32 s36, s30, 61440
    v_mul_u32_u24 v31, 1280, v3
    v_lshl_add_u32 v31, v2, 4, v31
    v_add_u32 v31, s36, v31
    s_lshl_b32 s38, s31, 7
    v_add_u32 v30, s38, v31
    s_mul_i32 s36, s51, 20480
    s_lshl_b32 s38, s50, 7
    s_add_u32 s36, s36, s38
    s_add_u32 s36, s36, 1024
    v_add_u32 v31, s36, v31
    global_load_dwordx4 v[224:227], v30, s[20:21] nt
    v_add_u32 v30, 10240, v30
    global_load_dwordx4 v[228:231], v30, s[20:21] nt
    v_add_u32 v30, 10240, v30
    global_load_dwordx4 v[232:235], v30, s[20:21] nt
    v_add_u32 v30, 10240, v30
    global_load_dwordx4 v[236:239], v30, s[20:21] nt
    v_add_u32 v30, 10240, v30
    global_load_dwordx4 v[240:243], v30, s[20:21] nt
    v_add_u32 v30, 10240, v30
    global_load_dwordx4 v[244:247], v30, s[20:21] nt
    global_load_dwordx4 v[248:251], v31, s[20:21] nt
    v_add_u32 v31, 10240, v31
    global_load_dwordx4 v[252:255], v31, s[20:21] nt
    global_load_dwordx4 v[80:83], v4, s[6:7] offset:128 nt
    global_load_dwordx4 v[84:87], v4, s[6:7] offset:256 nt
    v_add_u32 v4, s33, v4
    global_load_dwordx4 v[88:91], v4, s[6:7] offset:0 nt
    s_branch L_slot7
L_ga:
    v_and_b32 v29, 8, v1
    v_lshl_add_u32 v29, v2, 4, v29
    v_bfe_u32 v9, v1, 4, 1
    v_lshl_add_u32 v29, v9, 2, v29
    v_min_u32 v9, 92, v29
    s_mul_i32 s36, s30, 96
    v_add_u32 v9, s36, v9
    global_load_dword v28, v9, s[18:19]
    v_mov_b32 v11, 0
    s_mov_b32 s39, 2097152
L_wc:
    s_nop 4
    ds_read_b128 v[12:15], v11 offset:16
    s_waitcnt lgkmcnt(0)
    v_xor_b32 v8, s49, v12
    v_bitop3_b32 v8, v13, v8, s49 bitop3:0xde
    v_bitop3_b32 v8, v14, v8, s49 bitop3:0xde
    v_bitop3_b32 v8, v15, v8, s49 bitop3:0xde
    v_cmp_eq_u32 vcc, 0, v8
    s_nop 0
    s_cmp_eq_u64 vcc, exec
    s_cbranch_scc1 L_wcok
    s_sleep 1
    s_sub_u32 s39, s39, 1
    s_cmp_lg_u32 s39, 0
    s_cbranch_scc1 L_wc
L_wcok:
    s_lshl_b32 s36, s30, 14
    s_and_b32 s38, s32, 1
    s_lshl_b32 s38, s38, 10
    s_add_u32 s36, s36, s38
    s_add_u32 s36, s36, 528384
    v_lshl_add_u32 v26, v1, 4, s36
    v_add_u32 v27, 8192, v26
    global_load_dwordx4 v[224:227], v26, s[28:29] offset:-4096 sc1 nt
    global_load_dwordx4 v[228:231], v26, s[28:29] offset:-2048 sc1 nt
    global_load_dwordx4 v[232:235], v26, s[28:29] offset:0 sc1 nt
    global_load_dwordx4 v[236:239], v26, s[28:29] offset:2048 sc1 nt
    global_load_dwordx4 v[240:243], v27, s[28:29] offset:-4096 sc1 nt
    global_load_dwordx4 v[244:247], v27, s[28:29] offset:-2048 sc1 nt
    global_load_dwordx4 v[248:251], v27, s[28:29] offset:0 sc1 nt
    global_load_dwordx4 v[252:255], v27, s[28:29] offset:2048 sc1 nt
    global_load_dwordx4 v[104:107], v4, s[6:7] offset:128 nt
    global_load_dwordx4 v[108:111], v4, s[6:7] offset:256 nt
    v_add_u32 v4, s33, v4
    global_load_dwordx4 v[112:115], v4, s[6:7] offset:0 nt
    s_branch L_slot13
L_gp:
    global_load_dwordx4 v[120:123], v4, s[6:7] offset:256 nt
    v_add_u32 v4, s33, v4
    s_mov_b32 s39, 2097152
    s_branch L_pqchk
L_pq:
    s_lshl_b32 s36, s30, 14
    s_and_b32 s38, s32, 1
    s_lshl_b32 s38, s38, 10
    s_add_u32 s36, s36, s38
    s_add_u32 s36, s36, 528384
    v_lshl_add_u32 v26, v1, 4, s36
    v_add_u32 v27, 8192, v26
    global_load_dwordx4 v[224:227], v26, s[28:29] offset:-4096 sc1 nt
    global_load_dwordx4 v[228:231], v26, s[28:29] offset:-2048 sc1 nt
    global_load_dwordx4 v[232:235], v26, s[28:29] offset:0 sc1 nt
    global_load_dwordx4 v[236:239], v26, s[28:29] offset:2048 sc1 nt
    global_load_dwordx4 v[240:243], v27, s[28:29] offset:-4096 sc1 nt
    global_load_dwordx4 v[244:247], v27, s[28:29] offset:-2048 sc1 nt
    global_load_dwordx4 v[248:251], v27, s[28:29] offset:0 sc1 nt
    global_load_dwordx4 v[252:255], v27, s[28:29] offset:2048 sc1 nt
    s_waitcnt vmcnt(0)
L_pqchk:
    v_xor_b32 v8, s49, v225
    v_bitop3_b32 v8, v227, v8, s49 bitop3:0xde
    v_bitop3_b32 v8, v229, v8, s49 bitop3:0xde
    v_bitop3_b32 v8, v231, v8, s49 bitop3:0xde
    v_bitop3_b32 v8, v233, v8, s49 bitop3:0xde
    v_bitop3_b32 v8, v235, v8, s49 bitop3:0xde
    v_bitop3_b32 v8, v237, v8, s49 bitop3:0xde
    v_bitop3_b32 v8, v239, v8, s49 bitop3:0xde
    v_bitop3_b32 v8, v241, v8, s49 bitop3:0xde
    v_bitop3_b32 v8, v243, v8, s49 bitop3:0xde
    v_bitop3_b32 v8, v245, v8, s49 bitop3:0xde
    v_bitop3_b32 v8, v247, v8, s49 bitop3:0xde
    v_bitop3_b32 v8, v249, v8, s49 bitop3:0xde
    v_bitop3_b32 v8, v251, v8, s49 bitop3:0xde
    v_bitop3_b32 v8, v253, v8, s49 bitop3:0xde
    v_bitop3_b32 v8, v255, v8, s49 bitop3:0xde
    v_cmp_eq_u32 vcc, 0, v8
    s_nop 0
    s_cmp_eq_u64 vcc, exec
    s_cbranch_scc1 L_pqok
    s_sleep 4
    s_sub_u32 s39, s39, 1
    s_cmp_lg_u32 s39, 0
    s_cbranch_scc1 L_pq
L_pqok:
    v_add_f32 v224, v224, v228
    v_add_f32 v226, v226, v230
    v_add_f32 v232, v232, v236
    v_add_f32 v234, v234, v238
    v_add_f32 v240, v240, v244
    v_add_f32 v242, v242, v246
    v_add_f32 v248, v248, v252
    v_add_f32 v250, v250, v254
    v_add_f32 v224, v224, v232
    v_add_f32 v226, v226, v234
    v_add_f32 v240, v240, v248
    v_add_f32 v242, v242, v250
    v_add_f32 v224, v224, v240
    v_add_f32 v226, v226, v242
    s_and_b32 s38, s32, 1
    s_lshl_b32 s36, s38, 8
    s_add_u32 s36, s36, 64
    v_and_b32 v9, 8, v1
    v_lshl_add_u32 v9, v2, 4, v9
    v_bfe_u32 v10, v1, 4, 1
    v_lshl_add_u32 v9, v10, 2, v9
    v_lshrrev_b32 v10, 5, v1
    v_lshl_add_u32 v9, v10, 7, v9
    v_add_u32 v9, s36, v9
    v_cvt_pk_bf16_f32 v13, v224, v226
    v_mov_b32 v10, s49
    v_mov_b32 v11, 4
    s_cmp_eq_u32 s38, 0
    s_cbranch_scc1 L_gw
    s_getreg_b32 s53, hwreg(HW_REG_XCC_ID)
    s_and_b32 s53, s53, 7
    s_lshl_b32 s53, s53, 25
    s_add_u32 s53, s53, 0x41000000
    v_readlane_b32 s36, v226, 63
    s_nop 0
    s_cmp_eq_u32 s36, s53
    s_cselect_b32 s36, 1, 0
    s_xor_b32 s36, s36, s49
    v_mov_b32 v10, s36
    v_mov_b32 v11, 0
    v_lshlrev_b32 v14, 16, v13
    v_and_b32 v15, 0xffff0000, v13
    v_lshlrev_b32 v16, 16, v28
    v_and_b32 v17, 0xffff0000, v28
    v_add_f32 v14, v14, v16
    v_add_f32 v15, v15, v17
    v_cvt_pk_bf16_f32 v14, 0, v14
    v_cvt_pk_bf16_f32 v15, 0, v15
    v_max_f32 v14, 0, v14
    v_max_f32 v15, 0, v15
    v_mul_f32 v14, v14, v14
    v_mul_f32 v15, v15, v15
    s_mov_b32 exec_lo, 0
    v_cvt_pk_bf16_f32 v13, v14, v15
    s_mov_b32 exec_lo, -1
L_gw:
    ds_write_b32 v9, v13
    s_waitcnt lgkmcnt(0)
    ds_write_b32 v11, v10 offset:0
    s_branch L_slot15
L_mc:
    global_load_dwordx4 v[148:151], v4, s[6:7] offset:0 nt
    s_mov_b32 s39, 2097152
    v_mov_b32 v11, 0
    v_lshlrev_b32 v9, 1, v3
    s_lshl_b32 s36, s51, 5
    v_add_u32 v10, s36, v9
L_wh:
    s_nop 4
    ds_read_b32 v8, v11 offset:0
    s_waitcnt lgkmcnt(0)
    v_readfirstlane_b32 s36, v8
    s_nop 0
    s_xor_b32 s36, s36, s49
    s_cmp_lt_u32 s36, 2
    s_cbranch_scc1 L_whok
    s_sleep 2
    s_sub_u32 s39, s39, 1
    s_cmp_lg_u32 s39, 0
    s_cbranch_scc1 L_wh
L_whok:
    ds_read_u16 v12, v9 offset:448
    ds_read_u16 v13, v9 offset:464
    ds_read_u16 v14, v9 offset:480
    ds_read_u16 v15, v9 offset:496
    ds_read_u16 v16, v9 offset:512
    ds_read_u16 v17, v9 offset:528
    ds_read_u16 v18, v10 offset:448
    ds_read_u16 v19, v10 offset:464
    v_lshrrev_b32 v30, 5, v1
    v_lshl_add_u32 v30, v30, 8, v7
    s_waitcnt lgkmcnt(0)
    v_lshl_or_b32 v12, v12, 16, v12
    v_lshl_or_b32 v13, v13, 16, v13
    v_lshl_or_b32 v14, v14, 16, v14
    v_lshl_or_b32 v15, v15, 16, v15
    v_lshl_or_b32 v16, v16, 16, v16
    v_lshl_or_b32 v17, v17, 16, v17
    v_lshl_or_b32 v18, v18, 16, v18
    v_lshl_or_b32 v19, v19, 16, v19
    v_and_b32 v192, v12, v60
    v_and_b32 v193, v12, v61
    v_and_b32 v194, v12, v62
    v_and_b32 v195, v12, v63
    v_and_b32 v196, v13, v60
    v_and_b32 v197, v13, v61
    v_and_b32 v198, v13, v62
    v_and_b32 v199, v13, v63
    v_and_b32 v200, v14, v60
    v_and_b32 v201, v14, v61
    v_and_b32 v202, v14, v62
    v_and_b32 v203, v14, v63
    v_and_b32 v204, v15, v60
    v_and_b32 v205, v15, v61
    v_and_b32 v206, v15, v62
    v_and_b32 v207, v15, v63
    v_and_b32 v208, v16, v60
    v_and_b32 v209, v16, v61
    v_and_b32 v210, v16, v62
    v_and_b32 v211, v16, v63
    v_and_b32 v212, v17, v60
    v_and_b32 v213, v17, v61
    v_and_b32 v214, v17, v62
    v_and_b32 v215, v17, v63
    v_and_b32 v216, v18, v60
    v_and_b32 v217, v18, v61
    v_and_b32 v218, v18, v62
    v_and_b32 v219, v18, v63
    v_and_b32 v220, v19, v60
    v_and_b32 v221, v19, v61
    v_and_b32 v222, v19, v62
    v_and_b32 v223, v19, v63
    v_mfma_f32_16x16x32_bf16 v[32:35], v[192:195], v[224:227], 0
    v_mfma_f32_16x16x32_bf16 v[32:35], v[196:199], v[228:231], v[32:35]
    v_mfma_f32_16x16x32_bf16 v[32:35], v[200:203], v[232:235], v[32:35]
    v_mfma_f32_16x16x32_bf16 v[32:35], v[204:207], v[236:239], v[32:35]
    v_mfma_f32_16x16x32_bf16 v[32:35], v[208:211], v[240:243], v[32:35]
    v_mfma_f32_16x16x32_bf16 v[32:35], v[212:215], v[244:247], v[32:35]
    v_mfma_f32_16x16x32_bf16 v[36:39], v[216:219], v[248:251], 0
    v_mfma_f32_16x16x32_bf16 v[36:39], v[220:223], v[252:255], v[36:39]
    s_mov_b64 exec, s[62:63]
    s_nop 4
    ds_write_b128 v30, v[32:35] offset:768
    s_nop 0
    ds_write_b128 v30, v[36:39] offset:1280
    s_mov_b64 exec, -1
L_last:
    s_branch L_slot22
.section .rodata,"a"
.p2align 6
.amdhsa_kernel recurrent_scan__sliding_block_cached__dense_activation_squared_relu__decode_kernel
  .amdhsa_next_free_vgpr 256
  .amdhsa_next_free_sgpr 102
  .amdhsa_accum_offset 256
  .amdhsa_group_segment_fixed_size 0
  .amdhsa_kernarg_size 104
  .amdhsa_user_sgpr_count 2
  .amdhsa_user_sgpr_kernarg_segment_ptr 1
  .amdhsa_system_sgpr_workgroup_id_x 1
  .amdhsa_float_denorm_mode_32 3
.end_amdhsa_kernel
```
